```python
import torch

def _softmax(x, axis=-1):
    return torch.softmax(x, dim=axis)
def _gelu(x):
    return torch.nn.functional.gelu(x, approximate="tanh")
def _silu(x):
    return torch.nn.functional.silu(x)
def _sigmoid(x):
    return torch.sigmoid(x)
def _layernorm(x, axis=-1, eps=1e-5):
    m = x.mean(dim=axis, keepdim=True)
    v = x.var(dim=axis, keepdim=True, unbiased=False)
    return (x - m) / torch.sqrt(v + eps)
def _scatter_add(tgt, idx, src, axis=0):
    return tgt.clone().index_add_(axis, idx, src)
def _segment_sum(src, seg, n):
    out = torch.zeros((n,) + src.shape[1:], dtype=src.dtype)
    return out.index_add_(0, seg, src)
def _pad(x, pw):
    flat = tuple(v for pair in reversed(pw) for v in pair)
    return torch.nn.functional.pad(x, flat)

kernel_name = 'standalone__sequential_behavior_din__recsys'

def setup_inputs():

    _w = (lambda a: (lambda t: t.to(torch.bfloat16) if t.is_floating_point() else t)(torch.as_tensor(a)))
    B, L, D = 16384, 200, 16
    H = D
    return {
        "target": _w((lambda *s: torch.randn(*s, dtype=torch.bfloat16) * 1.6)(B, D)),
        "hist": _w((lambda *s: torch.randn(*s, dtype=torch.bfloat16) * 1.6)(B, L, D)),
        "mask": _w((lambda lo, hi, *s: torch.randint(lo, hi, s))(0, 2, B, L).to(float)),
        "w1": _w((lambda *s: torch.randn(*s, dtype=torch.bfloat16) * 1.6)(4 * D, H) * (4 * D) ** -0.5),
        "b1": _w((lambda *s: torch.randn(*s, dtype=torch.bfloat16) * 1.6)(H) * 0.1),
        "w2": _w((lambda *s: torch.randn(*s, dtype=torch.bfloat16) * 0.05)(H, 1) * H ** -0.5),
        "b2": _w((lambda *s: torch.randn(*s, dtype=torch.bfloat16) * 0.05)(1) * 0.1),
    }

def reference(target, hist, mask, w1, b1, w2, b2):
    L = hist.shape[1]
    tgt = (lambda x, n, axis: torch.repeat_interleave(x, n, dim=axis))(target[:, None, :], L, axis=1)
    feat = torch.concatenate([hist, tgt, hist - tgt, hist * tgt], axis=-1)
    h = _sigmoid(feat @ w1 + b1)
    scores = (h @ w2 + b2)[..., 0] * mask
    return torch.einsum('bl,bld->bd', scores, hist)
```

```asm
; @launch grid=(512,1,1) block=(256,1,1) lds=60160
.amdgcn_target "amdgcn-amd-amdhsa--gfx950"
.text
.globl standalone__sequential_behavior_din__recsys_kernel
.p2align 8
.type standalone__sequential_behavior_din__recsys_kernel,@function
standalone__sequential_behavior_din__recsys_kernel:
    s_cmp_ge_u32 s2, 512
    s_cbranch_scc1 L_end
    s_load_dwordx16 s[52:67], s[0:1], 0
    v_lshrrev_b32 v82, 6, v0
    v_and_b32 v1, 63, v0
    v_readfirstlane_b32 s42, v82
    v_lshlrev_b32 v90, 4, v1
    v_lshlrev_b32 v11, 2, v1
    s_mul_i32 s40, s2, 4
    s_add_u32 s40, s40, s42
    s_mul_i32 s41, s42, 15040
    s_mov_b32 s18, 524288
    s_mov_b32 s19, 0x20000
    s_mov_b32 s10, 51200
    s_mov_b32 s11, 0x20000
    s_mov_b32 s14, 6553600
    s_mov_b32 s15, 0x20000
    s_mov_b32 s22, 2048
    s_mov_b32 s23, 0x20000
    s_mov_b32 s26, 32
    s_mov_b32 s27, 0x20000
    s_mov_b32 s30, 32
    s_mov_b32 s31, 0x20000
    s_mov_b32 s34, 2
    s_mov_b32 s35, 0x20000
    s_mov_b32 s38, 524288
    s_mov_b32 s39, 0x20000
    s_mul_i32 s42, s40, 3200
    s_mul_i32 s49, s40, 256
    s_mul_i32 s45, s40, 51200
    s_add_u32 s46, s41, 3072
    s_mov_b32 s43, 0x07060302
    s_mov_b32 s50, 0xbfb8aa3b
    s_mov_b32 s51, 0xbfb8aa3b
    s_mov_b32 s44, 0xffff0000
    s_mov_b32 s48, 0x3f803f80
    v_and_b32 v82, 15, v1
    v_lshrrev_b32 v83, 4, v1
    v_lshlrev_b32 v115, 1, v82
    v_lshlrev_b32 v116, 3, v83
    v_mov_b32 v117, 0
    v_and_b32 v84, 1, v83
    v_lshlrev_b32 v84, 4, v84
    v_add_u32 v18, s41, v84
    v_lshl_add_u32 v19, v83, 4, s41
    v_lshl_add_u32 v2, v82, 5, v18
    v_lshl_add_u32 v3, v1, 3, s41
    v_lshrrev_b32 v6, 1, v1
    v_lshl_add_u32 v6, v6, 2, s46
    v_lshl_add_u32 v9, v83, 4, s46
    v_and_b32 v7, 1, v1
    v_lshlrev_b32 v7, 4, v7
    v_lshl_add_u32 v16, v1, 1, s41
    v_mov_b32 v17, 0xff00
    v_lshlrev_b32 v91, 4, v84
    v_lshl_add_u32 v91, v82, 3, v91
    v_add_u32 v91, s41, v91
    v_add_u32 v92, s41, v90
    v_mov_b32 v24, s48
    v_mov_b32 v25, s48
    v_mov_b32 v26, s48
    v_mov_b32 v27, s48
    v_lshlrev_b32 v12, 5, v1
    v_add_u32 v13, 2048, v12
    v_add_u32 v14, 4096, v12
    v_add_u32 v15, 6144, v12
    s_add_u32 m0, s41, 10912
    s_waitcnt lgkmcnt(0)
    s_mov_b64 s[12:13], s[56:57]
    s_bfm_b64 exec, 32, 0
    buffer_load_dwordx4 v90, s[12:15], s42 offen nt lds
    s_mov_b64 exec, -1
    s_add_u32 m0, s41, 4384
    s_mov_b64 s[20:21], s[58:59]
    buffer_load_dwordx4 v90, s[20:23], 0 offen lds
    buffer_load_dwordx4 v90, s[20:23], 0 offen offset:1024 lds
    s_add_u32 m0, s41, 14112
    s_mov_b64 s[16:17], s[52:53]
    buffer_load_dword v11, s[16:19], s49 offen nt lds
    s_mov_b64 s[24:25], s[60:61]
    s_mov_b64 s[28:29], s[62:63]
    s_mov_b64 s[32:33], s[64:65]
    buffer_load_ushort v114, v115, s[24:27], 0 offen
    buffer_load_dwordx2 v[20:21], v116, s[28:31], 0 offen
    buffer_load_ushort v10, v117, s[32:35], 0 offen
    s_add_u32 m0, s41, 10912
    s_nop 0
    buffer_load_dwordx4 v90, s[12:15], s42 offen offset:512 nt lds
    buffer_load_dwordx4 v90, s[12:15], s42 offen offset:1536 nt lds
    s_bfm_b64 exec, 40, 0
    buffer_load_dwordx4 v90, s[12:15], s42 offen offset:2560 nt lds
    s_mov_b64 exec, -1
    s_add_u32 s8, s54, s45
    s_addc_u32 s9, s55, 0
    s_mov_b64 s[36:37], s[66:67]
    s_mov_b32 s45, 0
    s_waitcnt vmcnt(9)
    ds_read_u16 v74, v16 offset:10912
    ds_read_u16 v75, v16 offset:11040
    ds_read_u16 v76, v16 offset:11168
    ds_read_u16 v77, v16 offset:11296
    s_waitcnt lgkmcnt(3)
    v_cmp_ne_u32 s[52:53], 0, v74
    s_waitcnt lgkmcnt(2)
    v_cmp_ne_u32 s[54:55], 0, v75
    s_waitcnt lgkmcnt(1)
    v_cmp_ne_u32 s[56:57], 0, v76
    s_waitcnt lgkmcnt(0)
    v_cmp_ne_u32 s[58:59], 0, v77
    s_nop 0
    s_and_b64 s[58:59], s[58:59], 0xff
    s_bcnt1_i32_b64 s42, s[52:53]
    v_mbcnt_lo_u32_b32 v82, s52, 0
    s_lshl2_add_u32 s60, s42, s46
    v_mbcnt_hi_u32_b32 v82, s53, v82
    s_bcnt1_i32_b64 s42, s[54:55]
    v_mbcnt_lo_u32_b32 v83, s54, 0
    s_lshl2_add_u32 s61, s42, s60
    v_mbcnt_hi_u32_b32 v83, s55, v83
    s_bcnt1_i32_b64 s42, s[56:57]
    v_mbcnt_lo_u32_b32 v84, s56, 0
    s_lshl2_add_u32 s62, s42, s61
    v_mbcnt_hi_u32_b32 v84, s57, v84
    s_bcnt1_i32_b64 s42, s[58:59]
    v_mbcnt_lo_u32_b32 v85, s58, 0
    s_lshl2_add_u32 s63, s42, s62
    v_mbcnt_hi_u32_b32 v85, s59, v85
    v_lshl_add_u32 v82, v82, 2, s46
    v_lshl_add_u32 v83, v83, 2, s60
    v_lshl_add_u32 v84, v84, 2, s61
    v_lshl_add_u32 v85, v85, 2, s62
    v_add_u32 v86, s63, v11
    s_mov_b64 exec, s[52:53]
    ds_write_b32 v82, v12
    s_mov_b64 exec, s[54:55]
    ds_write_b32 v83, v13
    s_mov_b64 exec, s[56:57]
    ds_write_b32 v84, v14
    s_mov_b64 exec, s[58:59]
    ds_write_b32 v85, v15
    s_mov_b64 exec, -1
    ds_write_b32 v86, v17 offset:0
    ds_write_b32 v86, v17 offset:256
    s_sub_u32 s42, s63, s46
    s_add_u32 s71, s42, 60
    s_lshr_b32 s71, s71, 6
    s_max_u32 s71, s71, 5
    s_add_u32 s42, s71, 1
    s_lshr_b32 s42, s42, 1
    s_lshl_b32 s42, s42, 7
    s_add_u32 s46, s46, s42
    ds_read_u16 v82, v6 offset:0
    ds_read_u16 v83, v6 offset:128
    v_add_u32 v6, 256, v6
    s_add_u32 m0, s41, 0
    s_waitcnt lgkmcnt(1)
    v_or_b32 v82, v82, v7
    buffer_load_dwordx4 v82, s[8:11], 0 offen nt lds
    s_add_u32 m0, s41, 1024
    s_waitcnt lgkmcnt(0)
    v_or_b32 v83, v83, v7
    buffer_load_dwordx4 v83, s[8:11], 0 offen nt lds
    s_mov_b32 s47, 2048
    ds_read_u16 v4, v6
    v_add_u32 v6, 128, v6
    s_waitcnt vmcnt(5)
    ds_read_b64_tr_b16 v[58:59], v91 offset:4384
    ds_read_b64_tr_b16 v[60:61], v91 offset:4512
    ds_read_b64_tr_b16 v[62:63], v91 offset:4896
    ds_read_b64_tr_b16 v[64:65], v91 offset:5024
    ds_read_b64_tr_b16 v[66:67], v91 offset:5408
    ds_read_b64_tr_b16 v[68:69], v91 offset:5536
    ds_read_b64_tr_b16 v[70:71], v91 offset:5920
    ds_read_b64_tr_b16 v[72:73], v91 offset:6048
    v_cmp_lt_u32 vcc, 31, v1
    v_mov_b32 v8, s44
    v_lshlrev_b32 v114, 16, v114
    v_cndmask_b32 v8, 0, v8, vcc
    v_mul_f32 v114, s50, v114
    v_cmp_gt_u32 vcc, 16, v1
    v_lshlrev_b32 v10, 16, v10
    v_mov_b32 v115, v114
    v_mov_b32 v116, v114
    v_mov_b32 v117, v114
    v_cndmask_b32 v10, 0, v10, vcc
    v_and_b32 v23, s44, v21
    v_lshlrev_b32 v22, 16, v21
    v_and_b32 v21, s44, v20
    v_lshlrev_b32 v20, 16, v20
    s_waitcnt lgkmcnt(0)
    v_lshlrev_b32 v94, 16, v58
    v_and_b32 v95, s44, v58
    v_lshlrev_b32 v96, 16, v59
    v_and_b32 v97, s44, v59
    v_lshlrev_b32 v98, 16, v60
    v_and_b32 v99, s44, v60
    v_lshlrev_b32 v100, 16, v61
    v_and_b32 v101, s44, v61
    v_lshlrev_b32 v82, 16, v62
    v_and_b32 v83, s44, v62
    v_lshlrev_b32 v84, 16, v63
    v_and_b32 v85, s44, v63
    v_lshlrev_b32 v86, 16, v64
    v_and_b32 v87, s44, v64
    v_lshlrev_b32 v88, 16, v65
    v_and_b32 v89, s44, v65
    v_lshlrev_b32 v74, 16, v66
    v_and_b32 v75, s44, v66
    v_lshlrev_b32 v76, 16, v67
    v_and_b32 v77, s44, v67
    v_lshlrev_b32 v78, 16, v68
    v_and_b32 v79, s44, v68
    v_lshlrev_b32 v80, 16, v69
    v_and_b32 v81, s44, v69
    v_lshlrev_b32 v102, 16, v70
    v_and_b32 v103, s44, v70
    v_lshlrev_b32 v104, 16, v71
    v_and_b32 v105, s44, v71
    v_lshlrev_b32 v106, 16, v72
    v_and_b32 v107, s44, v72
    v_lshlrev_b32 v108, 16, v73
    v_and_b32 v109, s44, v73
    v_pk_add_f32 v[94:95], v[94:95], v[74:75]
    v_pk_add_f32 v[96:97], v[96:97], v[76:77]
    v_pk_add_f32 v[98:99], v[98:99], v[78:79]
    v_pk_add_f32 v[100:101], v[100:101], v[80:81]
    v_pk_add_f32 v[82:83], v[82:83], v[74:75] neg_lo:[0,1] neg_hi:[0,1]
    v_pk_add_f32 v[84:85], v[84:85], v[76:77] neg_lo:[0,1] neg_hi:[0,1]
    v_pk_add_f32 v[86:87], v[86:87], v[78:79] neg_lo:[0,1] neg_hi:[0,1]
    v_pk_add_f32 v[88:89], v[88:89], v[80:81] neg_lo:[0,1] neg_hi:[0,1]
    v_pk_mul_f32 v[94:95], v[94:95], s[50:51]
    v_pk_mul_f32 v[96:97], v[96:97], s[50:51]
    v_pk_mul_f32 v[98:99], v[98:99], s[50:51]
    v_pk_mul_f32 v[100:101], v[100:101], s[50:51]
    v_pk_mul_f32 v[82:83], v[82:83], s[50:51]
    v_pk_mul_f32 v[84:85], v[84:85], s[50:51]
    v_pk_mul_f32 v[86:87], v[86:87], s[50:51]
    v_pk_mul_f32 v[88:89], v[88:89], s[50:51]
    v_pk_mul_f32 v[102:103], v[102:103], s[50:51]
    v_pk_mul_f32 v[104:105], v[104:105], s[50:51]
    v_pk_mul_f32 v[106:107], v[106:107], s[50:51]
    v_pk_mul_f32 v[108:109], v[108:109], s[50:51]
    v_and_b32 v74, v8, v82
    v_and_b32 v75, v8, v83
    v_and_b32 v76, v8, v84
    v_and_b32 v77, v8, v85
    v_and_b32 v78, v8, v86
    v_and_b32 v79, v8, v87
    v_and_b32 v80, v8, v88
    v_and_b32 v81, v8, v89
    v_pk_add_f32 v[74:75], v[82:83], v[74:75] neg_lo:[0,1] neg_hi:[0,1]
    v_pk_add_f32 v[76:77], v[84:85], v[76:77] neg_lo:[0,1] neg_hi:[0,1]
    v_pk_add_f32 v[78:79], v[86:87], v[78:79] neg_lo:[0,1] neg_hi:[0,1]
    v_pk_add_f32 v[80:81], v[88:89], v[80:81] neg_lo:[0,1] neg_hi:[0,1]
    v_perm_b32 v110, v75, v74, s43
    v_perm_b32 v111, v77, v76, s43
    v_perm_b32 v112, v79, v78, s43
    v_perm_b32 v113, v81, v80, s43
    s_waitcnt vmcnt(8)
    ds_read_b128 v[74:77], v19 offset:14112
    ds_read_b128 v[58:61], v18 offset:14112
    ds_read_b128 v[62:65], v18 offset:14144
    s_waitcnt lgkmcnt(2)
    v_lshlrev_b32 v82, 16, v74
    v_and_b32 v83, s44, v74
    v_lshlrev_b32 v84, 16, v75
    v_and_b32 v85, s44, v75
    v_lshlrev_b32 v86, 16, v76
    v_and_b32 v87, s44, v76
    v_lshlrev_b32 v88, 16, v77
    v_and_b32 v89, s44, v77
    s_waitcnt lgkmcnt(0)
    v_mfma_f32_16x16x32_bf16 v[50:53], v[58:61], v[110:113], v[114:117]
    v_mfma_f32_16x16x32_bf16 v[54:57], v[62:65], v[110:113], v[114:117]
    v_pk_fma_f32 v[82:83], v[82:83], v[102:103], v[94:95]
    v_pk_fma_f32 v[84:85], v[84:85], v[104:105], v[96:97]
    v_pk_fma_f32 v[86:87], v[86:87], v[106:107], v[98:99]
    v_pk_fma_f32 v[88:89], v[88:89], v[108:109], v[100:101]
    v_and_b32 v74, s44, v82
    v_and_b32 v75, s44, v83
    v_and_b32 v76, s44, v84
    v_and_b32 v77, s44, v85
    v_and_b32 v78, s44, v86
    v_and_b32 v79, s44, v87
    v_and_b32 v80, s44, v88
    v_and_b32 v81, s44, v89
    v_perm_b32 v42, v83, v82, s43
    v_perm_b32 v43, v85, v84, s43
    v_perm_b32 v44, v87, v86, s43
    v_perm_b32 v45, v89, v88, s43
    v_pk_add_f32 v[74:75], v[82:83], v[74:75] neg_lo:[0,1] neg_hi:[0,1]
    v_pk_add_f32 v[76:77], v[84:85], v[76:77] neg_lo:[0,1] neg_hi:[0,1]
    v_pk_add_f32 v[78:79], v[86:87], v[78:79] neg_lo:[0,1] neg_hi:[0,1]
    v_pk_add_f32 v[80:81], v[88:89], v[80:81] neg_lo:[0,1] neg_hi:[0,1]
    v_perm_b32 v46, v75, v74, s43
    v_perm_b32 v47, v77, v76, s43
    v_perm_b32 v48, v79, v78, s43
    v_perm_b32 v49, v81, v80, s43
    v_permlane32_swap_b32 v42, v46
    v_permlane32_swap_b32 v43, v47
    v_permlane32_swap_b32 v44, v48
    v_permlane32_swap_b32 v45, v49
    v_or_b32 v8, v4, v7
    v_mov_b32 v4, v2
    v_mov_b32 v5, v3
    s_waitcnt vmcnt(2)
    v_mov_b32 v93, 0
    ds_read_b128 v[74:77], v92 offset:10912
    ds_read_b128 v[78:81], v92 offset:11936
    s_waitcnt lgkmcnt(1)
    v_pk_sub_u16 v82, v74, s48
    v_pk_sub_u16 v83, v75, s48
    v_pk_sub_u16 v84, v76, s48
    v_pk_sub_u16 v85, v77, s48
    v_pk_min_u16 v82, v82, v74
    v_pk_min_u16 v83, v83, v75
    v_pk_min_u16 v84, v84, v76
    v_pk_min_u16 v85, v85, v77
    v_or3_b32 v93, v93, v82, v83
    v_or3_b32 v93, v93, v84, v85
    s_waitcnt lgkmcnt(0)
    v_pk_sub_u16 v86, v78, s48
    v_pk_sub_u16 v87, v79, s48
    v_pk_sub_u16 v88, v80, s48
    v_pk_sub_u16 v89, v81, s48
    v_pk_min_u16 v86, v86, v78
    v_pk_min_u16 v87, v87, v79
    v_pk_min_u16 v88, v88, v80
    v_pk_min_u16 v89, v89, v81
    v_or3_b32 v93, v93, v86, v87
    v_or3_b32 v93, v93, v88, v89
    ds_read_b128 v[74:77], v92 offset:12960
    ds_read_b128 v[78:81], v92 offset:13984
    s_waitcnt lgkmcnt(1)
    v_pk_sub_u16 v82, v74, s48
    v_pk_sub_u16 v83, v75, s48
    v_pk_sub_u16 v84, v76, s48
    v_pk_sub_u16 v85, v77, s48
    v_pk_min_u16 v82, v82, v74
    v_pk_min_u16 v83, v83, v75
    v_pk_min_u16 v84, v84, v76
    v_pk_min_u16 v85, v85, v77
    v_or3_b32 v93, v93, v82, v83
    v_or3_b32 v93, v93, v84, v85
    s_waitcnt lgkmcnt(0)
    s_bfm_b64 exec, 8, 0
    v_pk_sub_u16 v86, v78, s48
    v_pk_sub_u16 v87, v79, s48
    v_pk_sub_u16 v88, v80, s48
    v_pk_sub_u16 v89, v81, s48
    v_pk_min_u16 v86, v86, v78
    v_pk_min_u16 v87, v87, v79
    v_pk_min_u16 v88, v88, v80
    v_pk_min_u16 v89, v89, v81
    v_or3_b32 v93, v93, v86, v87
    v_or3_b32 v93, v93, v88, v89
    s_mov_b64 exec, -1
    v_cmp_ne_u32 s[68:69], 0, v93
    s_nop 0
    s_cmp_lg_u64 s[68:69], 0
    s_cbranch_scc1 L_general
    s_mov_b32 s72, 3
L_pairf:
    s_mov_b32 s70, s71
    v_mov_b64 v[28:29], 0
    v_mov_b64 v[32:33], 0
    v_mov_b64 v[30:31], 0
    v_mov_b64 v[34:35], 0
    ds_read_u16 v74, v16 offset:11312
    ds_read_u16 v75, v16 offset:11440
    ds_read_u16 v76, v16 offset:11568
    ds_read_u16 v77, v16 offset:11696
    v_add_u32 v12, 6400, v12
    v_add_u32 v13, 6400, v13
    v_add_u32 v14, 6400, v14
    v_add_u32 v15, 6400, v15
    s_waitcnt lgkmcnt(3)
    v_cmp_ne_u32 s[52:53], 0, v74
    s_waitcnt lgkmcnt(2)
    v_cmp_ne_u32 s[54:55], 0, v75
    s_waitcnt lgkmcnt(1)
    v_cmp_ne_u32 s[56:57], 0, v76
    s_waitcnt lgkmcnt(0)
    v_cmp_ne_u32 s[58:59], 0, v77
    s_nop 0
    s_and_b64 s[58:59], s[58:59], 0xff
    s_bcnt1_i32_b64 s42, s[52:53]
    v_mbcnt_lo_u32_b32 v82, s52, 0
    s_lshl2_add_u32 s60, s42, s46
    v_mbcnt_hi_u32_b32 v82, s53, v82
    s_bcnt1_i32_b64 s42, s[54:55]
    v_mbcnt_lo_u32_b32 v83, s54, 0
    s_lshl2_add_u32 s61, s42, s60
    v_mbcnt_hi_u32_b32 v83, s55, v83
    s_bcnt1_i32_b64 s42, s[56:57]
    v_mbcnt_lo_u32_b32 v84, s56, 0
    s_lshl2_add_u32 s62, s42, s61
    v_mbcnt_hi_u32_b32 v84, s57, v84
    s_bcnt1_i32_b64 s42, s[58:59]
    v_mbcnt_lo_u32_b32 v85, s58, 0
    s_lshl2_add_u32 s63, s42, s62
    v_mbcnt_hi_u32_b32 v85, s59, v85
    v_lshl_add_u32 v82, v82, 2, s46
    v_lshl_add_u32 v83, v83, 2, s60
    v_lshl_add_u32 v84, v84, 2, s61
    v_lshl_add_u32 v85, v85, 2, s62
    v_add_u32 v86, s63, v11
    s_mov_b64 exec, s[52:53]
    ds_write_b32 v82, v12
    s_mov_b64 exec, s[54:55]
    ds_write_b32 v83, v13
    s_mov_b64 exec, s[56:57]
    ds_write_b32 v84, v14
    s_mov_b64 exec, s[58:59]
    ds_write_b32 v85, v15
    s_mov_b64 exec, -1
    ds_write_b32 v86, v17 offset:0
    ds_write_b32 v86, v17 offset:256
    ds_write_b32 v86, v17 offset:512
    s_sub_u32 s42, s63, s46
    s_add_u32 s71, s42, 60
    s_lshr_b32 s71, s71, 6
    s_max_u32 s71, s71, 5
    s_add_u32 s42, s71, 1
    s_lshr_b32 s42, s42, 1
    s_lshl_b32 s42, s42, 7
    s_add_u32 s46, s46, s42
L_stepf0:
    s_add_u32 m0, s41, s47
    s_add_u32 s47, s47, 1024
    s_cmp_eq_u32 s47, 3072
    s_cselect_b32 s47, 0, s47
    s_waitcnt vmcnt(1)
    buffer_load_dwordx4 v8, s[8:11], 0 offen nt lds
    ds_read_b128 v[58:61], v4 offset:0
    ds_read_b128 v[62:65], v4 offset:512
    ds_read_b64_tr_b16 v[66:67], v5 offset:0
    ds_read_b64_tr_b16 v[68:69], v5 offset:512
    ds_read_u16 v8, v6
    s_add_u32 s45, s45, 1024
    s_cmp_eq_u32 s45, 3072
    s_cselect_b32 s45, 0, s45
    v_add_u32 v6, 128, v6
    v_add_u32 v4, s45, v2
    v_add_u32 v5, s45, v3
    s_waitcnt lgkmcnt(4)
    v_mfma_f32_16x16x32_bf16 v[74:77], v[58:61], v[42:45], v[50:53]
    s_waitcnt lgkmcnt(3)
    v_mfma_f32_16x16x32_bf16 v[78:81], v[62:65], v[42:45], v[50:53]
    s_waitcnt lgkmcnt(1)
    v_mfma_f32_16x16x32_bf16 v[32:35], v[24:27], v[66:69], v[32:35]
    s_waitcnt lgkmcnt(0)
    v_or_b32 v8, v8, v7
    s_nop 1
    v_exp_f32 v74, v74
    v_exp_f32 v75, v75
    v_exp_f32 v76, v76
    v_exp_f32 v77, v77
    v_exp_f32 v78, v78
    v_exp_f32 v79, v79
    v_exp_f32 v80, v80
    v_exp_f32 v81, v81
    v_pk_add_f32 v[74:75], v[74:75], 1.0 op_sel_hi:[1,0]
    v_pk_add_f32 v[76:77], v[76:77], 1.0 op_sel_hi:[1,0]
    v_pk_add_f32 v[78:79], v[78:79], 1.0 op_sel_hi:[1,0]
    v_pk_add_f32 v[80:81], v[80:81], 1.0 op_sel_hi:[1,0]
    v_rcp_f32 v74, v74
    v_rcp_f32 v75, v75
    v_rcp_f32 v76, v76
    v_rcp_f32 v77, v77
    v_rcp_f32 v78, v78
    v_rcp_f32 v79, v79
    v_rcp_f32 v80, v80
    v_rcp_f32 v81, v81
    v_cvt_pk_bf16_f32 v70, v74, v75
    v_cvt_pk_bf16_f32 v71, v76, v77
    v_cvt_pk_bf16_f32 v72, v78, v79
    v_cvt_pk_bf16_f32 v73, v80, v81
    s_addk_i32 s70, -2
    s_cmpk_gt_i32 s70, 1
    v_mfma_f32_16x16x32_bf16 v[28:31], v[70:73], v[66:69], v[28:31]
    s_cbranch_scc1 L_stepf0
    s_cmp_eq_u32 s70, 0
    s_cbranch_scc1 L_finf0
    s_add_u32 m0, s41, s47
    s_add_u32 s47, s47, 1024
    s_cmp_eq_u32 s47, 3072
    s_cselect_b32 s47, 0, s47
    s_waitcnt vmcnt(1)
    buffer_load_dwordx4 v8, s[8:11], 0 offen nt lds
    ds_read_b128 v[58:61], v4 offset:0
    ds_read_b64_tr_b16 v[66:67], v5 offset:0
    ds_read_u16 v8, v6
    s_add_u32 s45, s45, 1024
    s_cmp_eq_u32 s45, 3072
    s_cselect_b32 s45, 0, s45
    v_add_u32 v6, 128, v6
    v_add_u32 v4, s45, v2
    v_add_u32 v5, s45, v3
    s_waitcnt lgkmcnt(2)
    v_mfma_f32_16x16x32_bf16 v[74:77], v[58:61], v[42:45], v[50:53]
    s_waitcnt lgkmcnt(1)
    v_mfma_f32_16x16x16_bf16 v[32:35], v[24:25], v[66:67], v[32:35]
    s_waitcnt lgkmcnt(0)
    v_or_b32 v8, v8, v7
    s_nop 3
    v_exp_f32 v74, v74
    v_exp_f32 v75, v75
    v_exp_f32 v76, v76
    v_exp_f32 v77, v77
    v_pk_add_f32 v[74:75], v[74:75], 1.0 op_sel_hi:[1,0]
    v_pk_add_f32 v[76:77], v[76:77], 1.0 op_sel_hi:[1,0]
    v_rcp_f32 v74, v74
    v_rcp_f32 v75, v75
    v_rcp_f32 v76, v76
    v_rcp_f32 v77, v77
    v_cvt_pk_bf16_f32 v70, v74, v75
    v_cvt_pk_bf16_f32 v71, v76, v77
    s_nop 1
    v_mfma_f32_16x16x16_bf16 v[28:31], v[70:71], v[66:67], v[28:31]
L_finf0:
    v_mov_b32 v36, v37
    v_mov_b32 v37, v38
    v_mov_b32 v38, v39
    v_mul_f32 v39, v10, v32
    s_nop 3
    v_fmac_f32 v39, v20, v28
    v_fmac_f32 v39, v21, v29
    v_fmac_f32 v39, v22, v30
    v_fmac_f32 v39, v23, v31
    s_mov_b32 s70, s71
    v_mov_b64 v[28:29], 0
    v_mov_b64 v[32:33], 0
    v_mov_b64 v[30:31], 0
    v_mov_b64 v[34:35], 0
    s_cmp_eq_u32 s72, 0
    s_cbranch_scc1 L_nobuildf
    ds_read_u16 v74, v16 offset:11712
    ds_read_u16 v75, v16 offset:11840
    ds_read_u16 v76, v16 offset:11968
    ds_read_u16 v77, v16 offset:12096
    v_add_u32 v12, 6400, v12
    v_add_u32 v13, 6400, v13
    v_add_u32 v14, 6400, v14
    v_add_u32 v15, 6400, v15
    s_waitcnt lgkmcnt(3)
    v_cmp_ne_u32 s[52:53], 0, v74
    s_waitcnt lgkmcnt(2)
    v_cmp_ne_u32 s[54:55], 0, v75
    s_waitcnt lgkmcnt(1)
    v_cmp_ne_u32 s[56:57], 0, v76
    s_waitcnt lgkmcnt(0)
    v_cmp_ne_u32 s[58:59], 0, v77
    s_nop 0
    s_and_b64 s[58:59], s[58:59], 0xff
    s_bcnt1_i32_b64 s42, s[52:53]
    v_mbcnt_lo_u32_b32 v82, s52, 0
    s_lshl2_add_u32 s60, s42, s46
    v_mbcnt_hi_u32_b32 v82, s53, v82
    s_bcnt1_i32_b64 s42, s[54:55]
    v_mbcnt_lo_u32_b32 v83, s54, 0
    s_lshl2_add_u32 s61, s42, s60
    v_mbcnt_hi_u32_b32 v83, s55, v83
    s_bcnt1_i32_b64 s42, s[56:57]
    v_mbcnt_lo_u32_b32 v84, s56, 0
    s_lshl2_add_u32 s62, s42, s61
    v_mbcnt_hi_u32_b32 v84, s57, v84
    s_bcnt1_i32_b64 s42, s[58:59]
    v_mbcnt_lo_u32_b32 v85, s58, 0
    s_lshl2_add_u32 s63, s42, s62
    v_mbcnt_hi_u32_b32 v85, s59, v85
    v_lshl_add_u32 v82, v82, 2, s46
    v_lshl_add_u32 v83, v83, 2, s60
    v_lshl_add_u32 v84, v84, 2, s61
    v_lshl_add_u32 v85, v85, 2, s62
    v_add_u32 v86, s63, v11
    s_mov_b64 exec, s[52:53]
    ds_write_b32 v82, v12
    s_mov_b64 exec, s[54:55]
    ds_write_b32 v83, v13
    s_mov_b64 exec, s[56:57]
    ds_write_b32 v84, v14
    s_mov_b64 exec, s[58:59]
    ds_write_b32 v85, v15
    s_mov_b64 exec, -1
    ds_write_b32 v86, v17 offset:0
    ds_write_b32 v86, v17 offset:256
    ds_write_b32 v86, v17 offset:512
    s_sub_u32 s42, s63, s46
    s_add_u32 s71, s42, 60
    s_lshr_b32 s71, s71, 6
    s_max_u32 s71, s71, 5
    s_add_u32 s42, s71, 1
    s_lshr_b32 s42, s42, 1
    s_lshl_b32 s42, s42, 7
    s_add_u32 s46, s46, s42
L_nobuildf:
L_stepf1:
    s_add_u32 m0, s41, s47
    s_add_u32 s47, s47, 1024
    s_cmp_eq_u32 s47, 3072
    s_cselect_b32 s47, 0, s47
    s_waitcnt vmcnt(1)
    buffer_load_dwordx4 v8, s[8:11], 0 offen nt lds
    ds_read_b128 v[58:61], v4 offset:0
    ds_read_b128 v[62:65], v4 offset:512
    ds_read_b64_tr_b16 v[66:67], v5 offset:0
    ds_read_b64_tr_b16 v[68:69], v5 offset:512
    ds_read_u16 v8, v6
    s_add_u32 s45, s45, 1024
    s_cmp_eq_u32 s45, 3072
    s_cselect_b32 s45, 0, s45
    v_add_u32 v6, 128, v6
    v_add_u32 v4, s45, v2
    v_add_u32 v5, s45, v3
    s_waitcnt lgkmcnt(4)
    v_mfma_f32_16x16x32_bf16 v[74:77], v[58:61], v[46:49], v[54:57]
    s_waitcnt lgkmcnt(3)
    v_mfma_f32_16x16x32_bf16 v[78:81], v[62:65], v[46:49], v[54:57]
    s_waitcnt lgkmcnt(1)
    v_mfma_f32_16x16x32_bf16 v[32:35], v[24:27], v[66:69], v[32:35]
    s_waitcnt lgkmcnt(0)
    v_or_b32 v8, v8, v7
    s_nop 1
    v_exp_f32 v74, v74
    v_exp_f32 v75, v75
    v_exp_f32 v76, v76
    v_exp_f32 v77, v77
    v_exp_f32 v78, v78
    v_exp_f32 v79, v79
    v_exp_f32 v80, v80
    v_exp_f32 v81, v81
    v_pk_add_f32 v[74:75], v[74:75], 1.0 op_sel_hi:[1,0]
    v_pk_add_f32 v[76:77], v[76:77], 1.0 op_sel_hi:[1,0]
    v_pk_add_f32 v[78:79], v[78:79], 1.0 op_sel_hi:[1,0]
    v_pk_add_f32 v[80:81], v[80:81], 1.0 op_sel_hi:[1,0]
    v_rcp_f32 v74, v74
    v_rcp_f32 v75, v75
    v_rcp_f32 v76, v76
    v_rcp_f32 v77, v77
    v_rcp_f32 v78, v78
    v_rcp_f32 v79, v79
    v_rcp_f32 v80, v80
    v_rcp_f32 v81, v81
    v_cvt_pk_bf16_f32 v70, v74, v75
    v_cvt_pk_bf16_f32 v71, v76, v77
    v_cvt_pk_bf16_f32 v72, v78, v79
    v_cvt_pk_bf16_f32 v73, v80, v81
    s_addk_i32 s70, -2
    s_cmpk_gt_i32 s70, 1
    v_mfma_f32_16x16x32_bf16 v[28:31], v[70:73], v[66:69], v[28:31]
    s_cbranch_scc1 L_stepf1
    s_cmp_eq_u32 s70, 0
    s_cbranch_scc1 L_finf1
    s_add_u32 m0, s41, s47
    s_add_u32 s47, s47, 1024
    s_cmp_eq_u32 s47, 3072
    s_cselect_b32 s47, 0, s47
    s_waitcnt vmcnt(1)
    buffer_load_dwordx4 v8, s[8:11], 0 offen nt lds
    ds_read_b128 v[58:61], v4 offset:0
    ds_read_b64_tr_b16 v[66:67], v5 offset:0
    ds_read_u16 v8, v6
    s_add_u32 s45, s45, 1024
    s_cmp_eq_u32 s45, 3072
    s_cselect_b32 s45, 0, s45
    v_add_u32 v6, 128, v6
    v_add_u32 v4, s45, v2
    v_add_u32 v5, s45, v3
    s_waitcnt lgkmcnt(2)
    v_mfma_f32_16x16x32_bf16 v[74:77], v[58:61], v[46:49], v[54:57]
    s_waitcnt lgkmcnt(1)
    v_mfma_f32_16x16x16_bf16 v[32:35], v[24:25], v[66:67], v[32:35]
    s_waitcnt lgkmcnt(0)
    v_or_b32 v8, v8, v7
    s_nop 3
    v_exp_f32 v74, v74
    v_exp_f32 v75, v75
    v_exp_f32 v76, v76
    v_exp_f32 v77, v77
    v_pk_add_f32 v[74:75], v[74:75], 1.0 op_sel_hi:[1,0]
    v_pk_add_f32 v[76:77], v[76:77], 1.0 op_sel_hi:[1,0]
    v_rcp_f32 v74, v74
    v_rcp_f32 v75, v75
    v_rcp_f32 v76, v76
    v_rcp_f32 v77, v77
    v_cvt_pk_bf16_f32 v70, v74, v75
    v_cvt_pk_bf16_f32 v71, v76, v77
    s_nop 1
    v_mfma_f32_16x16x16_bf16 v[28:31], v[70:71], v[66:67], v[28:31]
L_finf1:
    v_mul_f32 v40, v10, v32
    s_nop 6
    v_fmac_f32 v40, v20, v28
    v_fmac_f32 v40, v21, v29
    v_fmac_f32 v40, v22, v30
    v_fmac_f32 v40, v23, v31
    s_cmp_eq_u32 s72, 0
    s_nop 0
    v_permlane16_swap_b32 v39, v40
    v_add_f32 v39, v39, v40
    s_cbranch_scc1 L_donef
    s_sub_u32 s72, s72, 1
    v_add_u32 v16, 800, v16
    v_add_u32 v18, 64, v18
    v_add_u32 v19, 64, v19
    ds_read_b128 v[74:77], v19 offset:14112
    ds_read_b128 v[58:61], v18 offset:14112
    ds_read_b128 v[62:65], v18 offset:14144
    s_waitcnt lgkmcnt(2)
    v_lshlrev_b32 v82, 16, v74
    v_and_b32 v83, s44, v74
    v_lshlrev_b32 v84, 16, v75
    v_and_b32 v85, s44, v75
    v_lshlrev_b32 v86, 16, v76
    v_and_b32 v87, s44, v76
    v_lshlrev_b32 v88, 16, v77
    v_and_b32 v89, s44, v77
    s_waitcnt lgkmcnt(0)
    v_mfma_f32_16x16x32_bf16 v[50:53], v[58:61], v[110:113], v[114:117]
    v_mfma_f32_16x16x32_bf16 v[54:57], v[62:65], v[110:113], v[114:117]
    v_pk_fma_f32 v[82:83], v[82:83], v[102:103], v[94:95]
    v_pk_fma_f32 v[84:85], v[84:85], v[104:105], v[96:97]
    v_pk_fma_f32 v[86:87], v[86:87], v[106:107], v[98:99]
    v_pk_fma_f32 v[88:89], v[88:89], v[108:109], v[100:101]
    v_and_b32 v74, s44, v82
    v_and_b32 v75, s44, v83
    v_and_b32 v76, s44, v84
    v_and_b32 v77, s44, v85
    v_and_b32 v78, s44, v86
    v_and_b32 v79, s44, v87
    v_and_b32 v80, s44, v88
    v_and_b32 v81, s44, v89
    v_perm_b32 v42, v83, v82, s43
    v_perm_b32 v43, v85, v84, s43
    v_perm_b32 v44, v87, v86, s43
    v_perm_b32 v45, v89, v88, s43
    v_pk_add_f32 v[74:75], v[82:83], v[74:75] neg_lo:[0,1] neg_hi:[0,1]
    v_pk_add_f32 v[76:77], v[84:85], v[76:77] neg_lo:[0,1] neg_hi:[0,1]
    v_pk_add_f32 v[78:79], v[86:87], v[78:79] neg_lo:[0,1] neg_hi:[0,1]
    v_pk_add_f32 v[80:81], v[88:89], v[80:81] neg_lo:[0,1] neg_hi:[0,1]
    v_perm_b32 v46, v75, v74, s43
    v_perm_b32 v47, v77, v76, s43
    v_perm_b32 v48, v79, v78, s43
    v_perm_b32 v49, v81, v80, s43
    v_permlane32_swap_b32 v42, v46
    v_permlane32_swap_b32 v43, v47
    v_permlane32_swap_b32 v44, v48
    v_permlane32_swap_b32 v45, v49
    s_branch L_pairf
L_donef:
L_store:
    v_lshlrev_b32 v82, 1, v1
    v_permlane32_swap_b32 v36, v37
    v_add_f32 v36, v36, v37
    v_cvt_pk_bf16_f32 v36, v36, v36
    buffer_store_short v36, v82, s[36:39], s49 offen offset:0
    v_permlane32_swap_b32 v38, v39
    v_add_f32 v38, v38, v39
    v_cvt_pk_bf16_f32 v38, v38, v38
    buffer_store_short v38, v82, s[36:39], s49 offen offset:128
    s_waitcnt vmcnt(0)
    s_endpgm
L_general:
    s_add_u32 s46, s41, 3072
    v_lshlrev_b32 v12, 5, v1
    v_add_u32 v13, 2048, v12
    v_add_u32 v14, 4096, v12
    v_add_u32 v15, 6144, v12
    ds_read_u16 v74, v16 offset:10912
    ds_read_u16 v75, v16 offset:11040
    ds_read_u16 v76, v16 offset:11168
    ds_read_u16 v77, v16 offset:11296
    s_waitcnt lgkmcnt(3)
    v_cmp_ne_u32 s[52:53], 0, v74
    s_waitcnt lgkmcnt(2)
    v_cmp_ne_u32 s[54:55], 0, v75
    s_waitcnt lgkmcnt(1)
    v_cmp_ne_u32 s[56:57], 0, v76
    s_waitcnt lgkmcnt(0)
    v_cmp_ne_u32 s[58:59], 0, v77
    s_nop 0
    s_and_b64 s[58:59], s[58:59], 0xff
    s_bcnt1_i32_b64 s42, s[52:53]
    v_mbcnt_lo_u32_b32 v82, s52, 0
    s_lshl2_add_u32 s60, s42, s46
    v_mbcnt_hi_u32_b32 v82, s53, v82
    s_bcnt1_i32_b64 s42, s[54:55]
    v_mbcnt_lo_u32_b32 v83, s54, 0
    s_lshl2_add_u32 s61, s42, s60
    v_mbcnt_hi_u32_b32 v83, s55, v83
    s_bcnt1_i32_b64 s42, s[56:57]
    v_mbcnt_lo_u32_b32 v84, s56, 0
    s_lshl2_add_u32 s62, s42, s61
    v_mbcnt_hi_u32_b32 v84, s57, v84
    s_bcnt1_i32_b64 s42, s[58:59]
    v_mbcnt_lo_u32_b32 v85, s58, 0
    s_lshl2_add_u32 s63, s42, s62
    v_mbcnt_hi_u32_b32 v85, s59, v85
    v_lshl_add_u32 v82, v82, 2, s46
    v_lshl_or_b32 v74, v74, 16, v12
    v_lshl_add_u32 v83, v83, 2, s60
    v_lshl_or_b32 v75, v75, 16, v13
    v_lshl_add_u32 v84, v84, 2, s61
    v_lshl_or_b32 v76, v76, 16, v14
    v_lshl_add_u32 v85, v85, 2, s62
    v_lshl_or_b32 v77, v77, 16, v15
    v_add_u32 v86, s63, v11
    s_mov_b64 exec, s[52:53]
    ds_write_b32 v82, v74
    s_mov_b64 exec, s[54:55]
    ds_write_b32 v83, v75
    s_mov_b64 exec, s[56:57]
    ds_write_b32 v84, v76
    s_mov_b64 exec, s[58:59]
    ds_write_b32 v85, v77
    s_mov_b64 exec, -1
    ds_write_b32 v86, v17 offset:0
    ds_write_b32 v86, v17 offset:256
    s_sub_u32 s42, s63, s46
    s_add_u32 s71, s42, 60
    s_lshr_b32 s71, s71, 6
    s_max_u32 s71, s71, 5
    s_add_u32 s42, s71, 1
    s_lshr_b32 s42, s42, 1
    s_lshl_b32 s42, s42, 7
    s_add_u32 s46, s46, s42
    s_mov_b32 s72, 3
L_pairg:
    s_mov_b32 s70, s71
    v_mov_b64 v[28:29], 0
    v_mov_b64 v[32:33], 0
    v_mov_b64 v[30:31], 0
    v_mov_b64 v[34:35], 0
    ds_read_u16 v74, v16 offset:11312
    ds_read_u16 v75, v16 offset:11440
    ds_read_u16 v76, v16 offset:11568
    ds_read_u16 v77, v16 offset:11696
    v_add_u32 v12, 6400, v12
    v_add_u32 v13, 6400, v13
    v_add_u32 v14, 6400, v14
    v_add_u32 v15, 6400, v15
    s_waitcnt lgkmcnt(3)
    v_cmp_ne_u32 s[52:53], 0, v74
    s_waitcnt lgkmcnt(2)
    v_cmp_ne_u32 s[54:55], 0, v75
    s_waitcnt lgkmcnt(1)
    v_cmp_ne_u32 s[56:57], 0, v76
    s_waitcnt lgkmcnt(0)
    v_cmp_ne_u32 s[58:59], 0, v77
    s_nop 0
    s_and_b64 s[58:59], s[58:59], 0xff
    s_bcnt1_i32_b64 s42, s[52:53]
    v_mbcnt_lo_u32_b32 v82, s52, 0
    s_lshl2_add_u32 s60, s42, s46
    v_mbcnt_hi_u32_b32 v82, s53, v82
    s_bcnt1_i32_b64 s42, s[54:55]
    v_mbcnt_lo_u32_b32 v83, s54, 0
    s_lshl2_add_u32 s61, s42, s60
    v_mbcnt_hi_u32_b32 v83, s55, v83
    s_bcnt1_i32_b64 s42, s[56:57]
    v_mbcnt_lo_u32_b32 v84, s56, 0
    s_lshl2_add_u32 s62, s42, s61
    v_mbcnt_hi_u32_b32 v84, s57, v84
    s_bcnt1_i32_b64 s42, s[58:59]
    v_mbcnt_lo_u32_b32 v85, s58, 0
    s_lshl2_add_u32 s63, s42, s62
    v_mbcnt_hi_u32_b32 v85, s59, v85
    v_lshl_add_u32 v82, v82, 2, s46
    v_lshl_or_b32 v74, v74, 16, v12
    v_lshl_add_u32 v83, v83, 2, s60
    v_lshl_or_b32 v75, v75, 16, v13
    v_lshl_add_u32 v84, v84, 2, s61
    v_lshl_or_b32 v76, v76, 16, v14
    v_lshl_add_u32 v85, v85, 2, s62
    v_lshl_or_b32 v77, v77, 16, v15
    v_add_u32 v86, s63, v11
    s_mov_b64 exec, s[52:53]
    ds_write_b32 v82, v74
    s_mov_b64 exec, s[54:55]
    ds_write_b32 v83, v75
    s_mov_b64 exec, s[56:57]
    ds_write_b32 v84, v76
    s_mov_b64 exec, s[58:59]
    ds_write_b32 v85, v77
    s_mov_b64 exec, -1
    ds_write_b32 v86, v17 offset:0
    ds_write_b32 v86, v17 offset:256
    ds_write_b32 v86, v17 offset:512
    s_sub_u32 s42, s63, s46
    s_add_u32 s71, s42, 60
    s_lshr_b32 s71, s71, 6
    s_max_u32 s71, s71, 5
    s_add_u32 s42, s71, 1
    s_lshr_b32 s42, s42, 1
    s_lshl_b32 s42, s42, 7
    s_add_u32 s46, s46, s42
L_stepg0:
    s_add_u32 m0, s41, s47
    ds_read_b128 v[82:85], v9 offset:0
    ds_read_b128 v[86:89], v9 offset:64
    s_add_u32 s47, s47, 1024
    s_cmp_eq_u32 s47, 3072
    s_cselect_b32 s47, 0, s47
    s_waitcnt vmcnt(1)
    buffer_load_dwordx4 v8, s[8:11], 0 offen nt lds
    ds_read_b128 v[58:61], v4 offset:0
    ds_read_b128 v[62:65], v4 offset:512
    ds_read_b64_tr_b16 v[66:67], v5 offset:0
    ds_read_b64_tr_b16 v[68:69], v5 offset:512
    ds_read_u16 v8, v6
    s_add_u32 s45, s45, 1024
    s_cmp_eq_u32 s45, 3072
    s_cselect_b32 s45, 0, s45
    v_add_u32 v6, 128, v6
    v_add_u32 v4, s45, v2
    v_add_u32 v5, s45, v3
    s_waitcnt lgkmcnt(4)
    v_mfma_f32_16x16x32_bf16 v[74:77], v[58:61], v[42:45], v[50:53]
    s_waitcnt lgkmcnt(3)
    v_mfma_f32_16x16x32_bf16 v[78:81], v[62:65], v[42:45], v[50:53]
    v_add_u32 v9, 128, v9
    v_perm_b32 v90, v83, v82, s43
    v_perm_b32 v91, v85, v84, s43
    v_perm_b32 v92, v87, v86, s43
    v_perm_b32 v93, v89, v88, s43
    v_and_b32 v82, s44, v82
    v_and_b32 v83, s44, v83
    v_and_b32 v84, s44, v84
    v_and_b32 v85, s44, v85
    v_and_b32 v86, s44, v86
    v_and_b32 v87, s44, v87
    v_and_b32 v88, s44, v88
    v_and_b32 v89, s44, v89
    s_waitcnt lgkmcnt(1)
    v_mfma_f32_16x16x32_bf16 v[32:35], v[90:93], v[66:69], v[32:35]
    s_waitcnt lgkmcnt(0)
    v_or_b32 v8, v8, v7
    v_exp_f32 v74, v74
    v_exp_f32 v75, v75
    v_exp_f32 v76, v76
    v_exp_f32 v77, v77
    v_exp_f32 v78, v78
    v_exp_f32 v79, v79
    v_exp_f32 v80, v80
    v_exp_f32 v81, v81
    v_pk_add_f32 v[74:75], v[74:75], 1.0 op_sel_hi:[1,0]
    v_pk_add_f32 v[76:77], v[76:77], 1.0 op_sel_hi:[1,0]
    v_pk_add_f32 v[78:79], v[78:79], 1.0 op_sel_hi:[1,0]
    v_pk_add_f32 v[80:81], v[80:81], 1.0 op_sel_hi:[1,0]
    v_rcp_f32 v74, v74
    v_rcp_f32 v75, v75
    v_rcp_f32 v76, v76
    v_rcp_f32 v77, v77
    v_rcp_f32 v78, v78
    v_rcp_f32 v79, v79
    v_rcp_f32 v80, v80
    v_rcp_f32 v81, v81
    v_pk_mul_f32 v[74:75], v[74:75], v[82:83]
    v_pk_mul_f32 v[76:77], v[76:77], v[84:85]
    v_pk_mul_f32 v[78:79], v[78:79], v[86:87]
    v_pk_mul_f32 v[80:81], v[80:81], v[88:89]
    v_cvt_pk_bf16_f32 v70, v74, v75
    v_cvt_pk_bf16_f32 v71, v76, v77
    v_cvt_pk_bf16_f32 v72, v78, v79
    v_cvt_pk_bf16_f32 v73, v80, v81
    s_addk_i32 s70, -2
    s_cmpk_gt_i32 s70, 1
    v_mfma_f32_16x16x32_bf16 v[28:31], v[70:73], v[66:69], v[28:31]
    s_cbranch_scc1 L_stepg0
    s_cmp_eq_u32 s70, 0
    s_cbranch_scc1 L_fing0
    s_add_u32 m0, s41, s47
    ds_read_b128 v[82:85], v9 offset:0
    s_add_u32 s47, s47, 1024
    s_cmp_eq_u32 s47, 3072
    s_cselect_b32 s47, 0, s47
    s_waitcnt vmcnt(1)
    buffer_load_dwordx4 v8, s[8:11], 0 offen nt lds
    ds_read_b128 v[58:61], v4 offset:0
    ds_read_b64_tr_b16 v[66:67], v5 offset:0
    ds_read_u16 v8, v6
    s_add_u32 s45, s45, 1024
    s_cmp_eq_u32 s45, 3072
    s_cselect_b32 s45, 0, s45
    v_add_u32 v6, 128, v6
    v_add_u32 v4, s45, v2
    v_add_u32 v5, s45, v3
    s_waitcnt lgkmcnt(2)
    v_mfma_f32_16x16x32_bf16 v[74:77], v[58:61], v[42:45], v[50:53]
    v_add_u32 v9, 128, v9
    v_perm_b32 v90, v83, v82, s43
    v_perm_b32 v91, v85, v84, s43
    v_and_b32 v82, s44, v82
    v_and_b32 v83, s44, v83
    v_and_b32 v84, s44, v84
    v_and_b32 v85, s44, v85
    s_waitcnt lgkmcnt(1)
    v_mfma_f32_16x16x16_bf16 v[32:35], v[90:91], v[66:67], v[32:35]
    s_waitcnt lgkmcnt(0)
    v_or_b32 v8, v8, v7
    v_exp_f32 v74, v74
    v_exp_f32 v75, v75
    v_exp_f32 v76, v76
    v_exp_f32 v77, v77
    v_pk_add_f32 v[74:75], v[74:75], 1.0 op_sel_hi:[1,0]
    v_pk_add_f32 v[76:77], v[76:77], 1.0 op_sel_hi:[1,0]
    v_rcp_f32 v74, v74
    v_rcp_f32 v75, v75
    v_rcp_f32 v76, v76
    v_rcp_f32 v77, v77
    v_pk_mul_f32 v[74:75], v[74:75], v[82:83]
    v_pk_mul_f32 v[76:77], v[76:77], v[84:85]
    v_cvt_pk_bf16_f32 v70, v74, v75
    v_cvt_pk_bf16_f32 v71, v76, v77
    s_nop 1
    v_mfma_f32_16x16x16_bf16 v[28:31], v[70:71], v[66:67], v[28:31]
L_fing0:
    v_mov_b32 v36, v37
    v_mov_b32 v37, v38
    v_mov_b32 v38, v39
    v_mul_f32 v39, v10, v32
    s_nop 3
    v_fmac_f32 v39, v20, v28
    v_fmac_f32 v39, v21, v29
    v_fmac_f32 v39, v22, v30
    v_fmac_f32 v39, v23, v31
    s_mov_b32 s70, s71
    v_mov_b64 v[28:29], 0
    v_mov_b64 v[32:33], 0
    v_mov_b64 v[30:31], 0
    v_mov_b64 v[34:35], 0
    s_cmp_eq_u32 s72, 0
    s_cbranch_scc1 L_nobuildg
    ds_read_u16 v74, v16 offset:11712
    ds_read_u16 v75, v16 offset:11840
    ds_read_u16 v76, v16 offset:11968
    ds_read_u16 v77, v16 offset:12096
    v_add_u32 v12, 6400, v12
    v_add_u32 v13, 6400, v13
    v_add_u32 v14, 6400, v14
    v_add_u32 v15, 6400, v15
    s_waitcnt lgkmcnt(3)
    v_cmp_ne_u32 s[52:53], 0, v74
    s_waitcnt lgkmcnt(2)
    v_cmp_ne_u32 s[54:55], 0, v75
    s_waitcnt lgkmcnt(1)
    v_cmp_ne_u32 s[56:57], 0, v76
    s_waitcnt lgkmcnt(0)
    v_cmp_ne_u32 s[58:59], 0, v77
    s_nop 0
    s_and_b64 s[58:59], s[58:59], 0xff
    s_bcnt1_i32_b64 s42, s[52:53]
    v_mbcnt_lo_u32_b32 v82, s52, 0
    s_lshl2_add_u32 s60, s42, s46
    v_mbcnt_hi_u32_b32 v82, s53, v82
    s_bcnt1_i32_b64 s42, s[54:55]
    v_mbcnt_lo_u32_b32 v83, s54, 0
    s_lshl2_add_u32 s61, s42, s60
    v_mbcnt_hi_u32_b32 v83, s55, v83
    s_bcnt1_i32_b64 s42, s[56:57]
    v_mbcnt_lo_u32_b32 v84, s56, 0
    s_lshl2_add_u32 s62, s42, s61
    v_mbcnt_hi_u32_b32 v84, s57, v84
    s_bcnt1_i32_b64 s42, s[58:59]
    v_mbcnt_lo_u32_b32 v85, s58, 0
    s_lshl2_add_u32 s63, s42, s62
    v_mbcnt_hi_u32_b32 v85, s59, v85
    v_lshl_add_u32 v82, v82, 2, s46
    v_lshl_or_b32 v74, v74, 16, v12
    v_lshl_add_u32 v83, v83, 2, s60
    v_lshl_or_b32 v75, v75, 16, v13
    v_lshl_add_u32 v84, v84, 2, s61
    v_lshl_or_b32 v76, v76, 16, v14
    v_lshl_add_u32 v85, v85, 2, s62
    v_lshl_or_b32 v77, v77, 16, v15
    v_add_u32 v86, s63, v11
    s_mov_b64 exec, s[52:53]
    ds_write_b32 v82, v74
    s_mov_b64 exec, s[54:55]
    ds_write_b32 v83, v75
    s_mov_b64 exec, s[56:57]
    ds_write_b32 v84, v76
    s_mov_b64 exec, s[58:59]
    ds_write_b32 v85, v77
    s_mov_b64 exec, -1
    ds_write_b32 v86, v17 offset:0
    ds_write_b32 v86, v17 offset:256
    ds_write_b32 v86, v17 offset:512
    s_sub_u32 s42, s63, s46
    s_add_u32 s71, s42, 60
    s_lshr_b32 s71, s71, 6
    s_max_u32 s71, s71, 5
    s_add_u32 s42, s71, 1
    s_lshr_b32 s42, s42, 1
    s_lshl_b32 s42, s42, 7
    s_add_u32 s46, s46, s42
L_nobuildg:
L_stepg1:
    s_add_u32 m0, s41, s47
    ds_read_b128 v[82:85], v9 offset:0
    ds_read_b128 v[86:89], v9 offset:64
    s_add_u32 s47, s47, 1024
    s_cmp_eq_u32 s47, 3072
    s_cselect_b32 s47, 0, s47
    s_waitcnt vmcnt(1)
    buffer_load_dwordx4 v8, s[8:11], 0 offen nt lds
    ds_read_b128 v[58:61], v4 offset:0
    ds_read_b128 v[62:65], v4 offset:512
    ds_read_b64_tr_b16 v[66:67], v5 offset:0
    ds_read_b64_tr_b16 v[68:69], v5 offset:512
    ds_read_u16 v8, v6
    s_add_u32 s45, s45, 1024
    s_cmp_eq_u32 s45, 3072
    s_cselect_b32 s45, 0, s45
    v_add_u32 v6, 128, v6
    v_add_u32 v4, s45, v2
    v_add_u32 v5, s45, v3
    s_waitcnt lgkmcnt(4)
    v_mfma_f32_16x16x32_bf16 v[74:77], v[58:61], v[46:49], v[54:57]
    s_waitcnt lgkmcnt(3)
    v_mfma_f32_16x16x32_bf16 v[78:81], v[62:65], v[46:49], v[54:57]
    v_add_u32 v9, 128, v9
    v_perm_b32 v90, v83, v82, s43
    v_perm_b32 v91, v85, v84, s43
    v_perm_b32 v92, v87, v86, s43
    v_perm_b32 v93, v89, v88, s43
    v_and_b32 v82, s44, v82
    v_and_b32 v83, s44, v83
    v_and_b32 v84, s44, v84
    v_and_b32 v85, s44, v85
    v_and_b32 v86, s44, v86
    v_and_b32 v87, s44, v87
    v_and_b32 v88, s44, v88
    v_and_b32 v89, s44, v89
    s_waitcnt lgkmcnt(1)
    v_mfma_f32_16x16x32_bf16 v[32:35], v[90:93], v[66:69], v[32:35]
    s_waitcnt lgkmcnt(0)
    v_or_b32 v8, v8, v7
    v_exp_f32 v74, v74
    v_exp_f32 v75, v75
    v_exp_f32 v76, v76
    v_exp_f32 v77, v77
    v_exp_f32 v78, v78
    v_exp_f32 v79, v79
    v_exp_f32 v80, v80
    v_exp_f32 v81, v81
    v_pk_add_f32 v[74:75], v[74:75], 1.0 op_sel_hi:[1,0]
    v_pk_add_f32 v[76:77], v[76:77], 1.0 op_sel_hi:[1,0]
    v_pk_add_f32 v[78:79], v[78:79], 1.0 op_sel_hi:[1,0]
    v_pk_add_f32 v[80:81], v[80:81], 1.0 op_sel_hi:[1,0]
    v_rcp_f32 v74, v74
    v_rcp_f32 v75, v75
    v_rcp_f32 v76, v76
    v_rcp_f32 v77, v77
    v_rcp_f32 v78, v78
    v_rcp_f32 v79, v79
    v_rcp_f32 v80, v80
    v_rcp_f32 v81, v81
    v_pk_mul_f32 v[74:75], v[74:75], v[82:83]
    v_pk_mul_f32 v[76:77], v[76:77], v[84:85]
    v_pk_mul_f32 v[78:79], v[78:79], v[86:87]
    v_pk_mul_f32 v[80:81], v[80:81], v[88:89]
    v_cvt_pk_bf16_f32 v70, v74, v75
    v_cvt_pk_bf16_f32 v71, v76, v77
    v_cvt_pk_bf16_f32 v72, v78, v79
    v_cvt_pk_bf16_f32 v73, v80, v81
    s_addk_i32 s70, -2
    s_cmpk_gt_i32 s70, 1
    v_mfma_f32_16x16x32_bf16 v[28:31], v[70:73], v[66:69], v[28:31]
    s_cbranch_scc1 L_stepg1
    s_cmp_eq_u32 s70, 0
    s_cbranch_scc1 L_fing1
    s_add_u32 m0, s41, s47
    ds_read_b128 v[82:85], v9 offset:0
    s_add_u32 s47, s47, 1024
    s_cmp_eq_u32 s47, 3072
    s_cselect_b32 s47, 0, s47
    s_waitcnt vmcnt(1)
    buffer_load_dwordx4 v8, s[8:11], 0 offen nt lds
    ds_read_b128 v[58:61], v4 offset:0
    ds_read_b64_tr_b16 v[66:67], v5 offset:0
    ds_read_u16 v8, v6
    s_add_u32 s45, s45, 1024
    s_cmp_eq_u32 s45, 3072
    s_cselect_b32 s45, 0, s45
    v_add_u32 v6, 128, v6
    v_add_u32 v4, s45, v2
    v_add_u32 v5, s45, v3
    s_waitcnt lgkmcnt(2)
    v_mfma_f32_16x16x32_bf16 v[74:77], v[58:61], v[46:49], v[54:57]
    v_add_u32 v9, 128, v9
    v_perm_b32 v90, v83, v82, s43
    v_perm_b32 v91, v85, v84, s43
    v_and_b32 v82, s44, v82
    v_and_b32 v83, s44, v83
    v_and_b32 v84, s44, v84
    v_and_b32 v85, s44, v85
    s_waitcnt lgkmcnt(1)
    v_mfma_f32_16x16x16_bf16 v[32:35], v[90:91], v[66:67], v[32:35]
    s_waitcnt lgkmcnt(0)
    v_or_b32 v8, v8, v7
    v_exp_f32 v74, v74
    v_exp_f32 v75, v75
    v_exp_f32 v76, v76
    v_exp_f32 v77, v77
    v_pk_add_f32 v[74:75], v[74:75], 1.0 op_sel_hi:[1,0]
    v_pk_add_f32 v[76:77], v[76:77], 1.0 op_sel_hi:[1,0]
    v_rcp_f32 v74, v74
    v_rcp_f32 v75, v75
    v_rcp_f32 v76, v76
    v_rcp_f32 v77, v77
    v_pk_mul_f32 v[74:75], v[74:75], v[82:83]
    v_pk_mul_f32 v[76:77], v[76:77], v[84:85]
    v_cvt_pk_bf16_f32 v70, v74, v75
    v_cvt_pk_bf16_f32 v71, v76, v77
    s_nop 1
    v_mfma_f32_16x16x16_bf16 v[28:31], v[70:71], v[66:67], v[28:31]
L_fing1:
    v_mul_f32 v40, v10, v32
    s_nop 6
    v_fmac_f32 v40, v20, v28
    v_fmac_f32 v40, v21, v29
    v_fmac_f32 v40, v22, v30
    v_fmac_f32 v40, v23, v31
    s_cmp_eq_u32 s72, 0
    s_nop 0
    v_permlane16_swap_b32 v39, v40
    v_add_f32 v39, v39, v40
    s_cbranch_scc1 L_doneg
    s_sub_u32 s72, s72, 1
    v_add_u32 v16, 800, v16
    v_add_u32 v18, 64, v18
    v_add_u32 v19, 64, v19
    ds_read_b128 v[74:77], v19 offset:14112
    ds_read_b128 v[58:61], v18 offset:14112
    ds_read_b128 v[62:65], v18 offset:14144
    s_waitcnt lgkmcnt(2)
    v_lshlrev_b32 v82, 16, v74
    v_and_b32 v83, s44, v74
    v_lshlrev_b32 v84, 16, v75
    v_and_b32 v85, s44, v75
    v_lshlrev_b32 v86, 16, v76
    v_and_b32 v87, s44, v76
    v_lshlrev_b32 v88, 16, v77
    v_and_b32 v89, s44, v77
    s_waitcnt lgkmcnt(0)
    v_mfma_f32_16x16x32_bf16 v[50:53], v[58:61], v[110:113], v[114:117]
    v_mfma_f32_16x16x32_bf16 v[54:57], v[62:65], v[110:113], v[114:117]
    v_pk_fma_f32 v[82:83], v[82:83], v[102:103], v[94:95]
    v_pk_fma_f32 v[84:85], v[84:85], v[104:105], v[96:97]
    v_pk_fma_f32 v[86:87], v[86:87], v[106:107], v[98:99]
    v_pk_fma_f32 v[88:89], v[88:89], v[108:109], v[100:101]
    v_and_b32 v74, s44, v82
    v_and_b32 v75, s44, v83
    v_and_b32 v76, s44, v84
    v_and_b32 v77, s44, v85
    v_and_b32 v78, s44, v86
    v_and_b32 v79, s44, v87
    v_and_b32 v80, s44, v88
    v_and_b32 v81, s44, v89
    v_perm_b32 v42, v83, v82, s43
    v_perm_b32 v43, v85, v84, s43
    v_perm_b32 v44, v87, v86, s43
    v_perm_b32 v45, v89, v88, s43
    v_pk_add_f32 v[74:75], v[82:83], v[74:75] neg_lo:[0,1] neg_hi:[0,1]
    v_pk_add_f32 v[76:77], v[84:85], v[76:77] neg_lo:[0,1] neg_hi:[0,1]
    v_pk_add_f32 v[78:79], v[86:87], v[78:79] neg_lo:[0,1] neg_hi:[0,1]
    v_pk_add_f32 v[80:81], v[88:89], v[80:81] neg_lo:[0,1] neg_hi:[0,1]
    v_perm_b32 v46, v75, v74, s43
    v_perm_b32 v47, v77, v76, s43
    v_perm_b32 v48, v79, v78, s43
    v_perm_b32 v49, v81, v80, s43
    v_permlane32_swap_b32 v42, v46
    v_permlane32_swap_b32 v43, v47
    v_permlane32_swap_b32 v44, v48
    v_permlane32_swap_b32 v45, v49
    s_branch L_pairg
L_doneg:
    s_nop 1
    s_branch L_store
L_end:
    s_endpgm
.section .rodata,"a"
.p2align 6
.amdhsa_kernel standalone__sequential_behavior_din__recsys_kernel
  .amdhsa_next_free_vgpr 118
  .amdhsa_next_free_sgpr 73
  .amdhsa_accum_offset 120
  .amdhsa_group_segment_fixed_size 0
  .amdhsa_kernarg_size 80
  .amdhsa_user_sgpr_count 2
  .amdhsa_user_sgpr_kernarg_segment_ptr 1
  .amdhsa_system_sgpr_workgroup_id_x 1
.end_amdhsa_kernel
```
